```python
import torch

def _softmax(x, axis=-1):
    return torch.softmax(x, dim=axis)
def _gelu(x):
    return torch.nn.functional.gelu(x, approximate="tanh")
def _silu(x):
    return torch.nn.functional.silu(x)
def _sigmoid(x):
    return torch.sigmoid(x)
def _layernorm(x, axis=-1, eps=1e-5):
    m = x.mean(dim=axis, keepdim=True)
    v = x.var(dim=axis, keepdim=True, unbiased=False)
    return (x - m) / torch.sqrt(v + eps)
def _scatter_add(tgt, idx, src, axis=0):
    return tgt.clone().index_add_(axis, idx, src)
def _segment_sum(src, seg, n):
    out = torch.zeros((n,) + src.shape[1:], dtype=src.dtype)
    return out.index_add_(0, seg, src)
def _pad(x, pw):
    flat = tuple(v for pair in reversed(pw) for v in pair)
    return torch.nn.functional.pad(x, flat)

kernel_name = 'recurrent_scan__gqa_block_cached__glu_gated_glu__decode'

def setup_inputs():

    _w = (lambda a: (lambda t: t.to(torch.bfloat16) if t.is_floating_point() else t)(torch.as_tensor(a)))
    def _A_setup():
        B, Sq, D = 8, 1, 1024
        Hq, Hkv, Sk, Dh = 32, 4, 4096, 128
        assert Hq % Hkv == 0, (Hq, Hkv)
        return {
            "x": _w((lambda *s: torch.randn(*s, dtype=torch.bfloat16) * 0.05)(B, Sq, D)),
            "k_cache": _w((lambda *s: torch.randn(*s, dtype=torch.bfloat16) * 1.6)(B, Hkv, Sk, Dh)),
            "v_cache": _w((lambda *s: torch.randn(*s, dtype=torch.bfloat16) * 0.2)(B, Hkv, Sk, Dh)),
            "wq": _w((lambda *s: torch.randn(*s, dtype=torch.bfloat16) * 1.6)(D, Hq * Dh) * (D ** -0.5)),
            "wo": _w((lambda *s: torch.randn(*s, dtype=torch.bfloat16) * 0.2)(Hq * Dh, D) * ((Hq * Dh) ** -0.5)),
        }
    _A_in = _A_setup()

    def _B_setup():
        B, S, D, F = 8, 1, 1024, 3584
        return {
            "x": _w((lambda *s: torch.randn(*s, dtype=torch.bfloat16) * 0.05)(B, S, D)),
            "w_gate": _w((lambda *s: torch.randn(*s, dtype=torch.bfloat16) * 0.2)(D, F)),
            "w_up": _w((lambda *s: torch.randn(*s, dtype=torch.bfloat16) * 0.1)(D, F)),
            "w_down": _w((lambda *s: torch.randn(*s, dtype=torch.bfloat16) * 0.1)(F, D)),
        }
    _B_in = _B_setup()

    return {
        "A_x": _A_in["x"],
        "A_k_cache": _A_in["k_cache"],
        "A_v_cache": _A_in["v_cache"],
        "A_wq": _A_in["wq"],
        "A_wo": _A_in["wo"],
        "B_x": _B_in["x"],
        "B_w_gate": _B_in["w_gate"],
        "B_w_up": _B_in["w_up"],
        "B_w_down": _B_in["w_down"],
    }

def reference(A_x, A_k_cache, A_v_cache, A_wq, A_wo, B_x, B_w_gate, B_w_up, B_w_down):
    def _A_ref(x, k_cache, v_cache, wq, wo):
        B, Sq, D = x.shape
        Hq, Dh = 32, 128
        Hkv = k_cache.shape[1]
        rep = Hq // Hkv
        q = (lambda x, *d: x.permute(*d))((x @ wq).reshape(B, Sq, Hq, Dh), 0, 2, 1, 3)
        k = (lambda x, n, axis: torch.repeat_interleave(x, n, dim=axis))(k_cache, rep, axis=1)
        v = (lambda x, n, axis: torch.repeat_interleave(x, n, dim=axis))(v_cache, rep, axis=1)
        scores = torch.einsum("bhqd,bhkd->bhqk", q, k) * (Dh ** -0.5)
        p = _softmax(scores, axis=-1)
        o = torch.einsum("bhqk,bhkd->bhqd", p, v)
        return (lambda x, *d: x.permute(*d))(o, 0, 2, 1, 3).reshape(B, Sq, Hq * Dh) @ wo

    def _B_ref(x, w_gate, w_up, w_down):
        g = torch.einsum("bsd,df->bsf", x, w_gate)
        u = torch.einsum("bsd,df->bsf", x, w_up)
        h = _sigmoid(g) * u
        return torch.einsum("bsf,fd->bsd", h, w_down)

    x = A_x
    xn = _layernorm(x, axis=-1)
    s = _A_ref(xn, A_k_cache, A_v_cache, A_wq, A_wo)
    g = _silu(_B_ref(xn, B_w_gate, B_w_up, B_w_down))
    return x + s * g
```

```asm
; @launch grid=(256,1,1) block=(512,1,1) lds=139264
.amdgcn_target "amdgcn-amd-amdhsa--gfx950"
.text
.globl recurrent_scan__gqa_block_cached__glu_gated_glu__decode_kernel
.p2align 8
.type recurrent_scan__gqa_block_cached__glu_gated_glu__decode_kernel,@function
recurrent_scan__gqa_block_cached__glu_gated_glu__decode_kernel:
  s_cmp_ge_u32 s2, 256
  s_cbranch_scc1 L_done
  s_load_dwordx16 s[16:31], s[0:1], 0
  s_load_dwordx8 s[32:39], s[0:1], 64
  v_lshrrev_b32 v1, 6, v0
  v_and_b32 v2, 63, v0
  v_and_b32 v3, 15, v0
  v_readfirstlane_b32 s3, v1
  v_lshrrev_b32 v4, 4, v2
  s_mov_b32 s4, 0x05040100
  s_mov_b32 s5, 0x07060302
  s_mov_b32 s96, 0x3fb8aa3b
  s_mov_b32 s97, 0x3db504f3
  s_mov_b32 s95, 0xffffff00
  s_mov_b32 s15, 400000
  s_waitcnt lgkmcnt(0)
  s_load_dword s6, s[38:39], 0
  s_mov_b32 s40, s16
  s_and_b32 s41, s17, 0xffff
  s_mov_b32 s42, 0x4000
  s_mov_b32 s43, 0x20000
  s_mov_b32 s52, s22
  s_and_b32 s53, s23, 0xffff
  s_mov_b32 s54, 0x800000
  s_mov_b32 s55, 0x20000
  v_lshlrev_b32 v251, 4, v2
  s_lshl_b32 s94, s3, 11
  buffer_load_dwordx4 v[192:195], v251, s[40:43], s94 offen
  buffer_load_dwordx4 v[196:199], v251, s[40:43], s94 offen offset:1024
  v_lshrrev_b32 v6, 3, v3
  v_lshlrev_b32 v6, 2, v6
  v_add_u32 v6, v6, v4
  v_and_b32 v7, 7, v3
  v_mul_u32_u24 v1, 57344, v6
  v_lshl_add_u32 v1, v7, 4, v1
  v_lshlrev_b32 v6, 15, v6
  v_lshl_add_u32 v6, v7, 4, v6
  s_lshr_b32 s7, s2, 6
  s_lshl_b32 s7, s7, 3
  s_add_u32 s7, s7, s3
  s_lshl_b32 s7, s7, 18
  s_and_b32 s8, s2, 63
  s_lshl_b32 s8, s8, 7
  s_add_u32 s80, s7, s8
  s_add_u32 s81, s80, 8192
  s_add_u32 s82, s80, 16384
  s_add_u32 s83, s80, 24576
  buffer_load_dwordx4 v[16:19], v6, s[52:55], s80 offen nt
  buffer_load_dwordx4 v[20:23], v6, s[52:55], s81 offen nt
  buffer_load_dwordx4 v[24:27], v6, s[52:55], s82 offen nt
  buffer_load_dwordx4 v[28:31], v6, s[52:55], s83 offen nt
  s_mov_b32 s44, s18
  s_and_b32 s45, s19, 0xffff
  s_mov_b32 s46, 0x2000000
  s_mov_b32 s47, 0x20000
  s_mov_b32 s48, s20
  s_and_b32 s49, s21, 0xffff
  s_mov_b32 s50, 0x2000000
  s_mov_b32 s51, 0x20000
  s_and_b32 s7, s2, 1
  s_cmp_eq_u32 s7, 0
  s_cselect_b32 s56, s28, s30
  s_cselect_b32 s57, s29, s31
  s_and_b32 s57, s57, 0xffff
  s_mov_b32 s58, 7340032
  s_mov_b32 s59, 0x20000
  s_mov_b32 s60, s32
  s_and_b32 s61, s33, 0xffff
  s_mov_b32 s62, 0x700000
  s_mov_b32 s63, 0x20000
  s_mov_b32 s64, s24
  s_and_b32 s65, s25, 0xffff
  s_mov_b32 s66, 0x800000
  s_mov_b32 s67, 0x20000
  s_mov_b32 s68, s38
  s_and_b32 s69, s39, 0xffff
  s_mov_b32 s70, 0x1000000
  s_mov_b32 s71, 0x20000
  s_mov_b32 s72, s34
  s_and_b32 s73, s35, 0xffff
  s_mov_b32 s74, 0x4000
  s_mov_b32 s75, 0x20000
  s_and_b32 s76, s2, 31
  s_lshr_b32 s77, s2, 5
  s_lshl_b32 s7, s77, 8
  s_lshl_b32 s8, s76, 3
  s_add_u32 s14, s7, s8
  v_and_b32 v7, 7, v2
  v_lshlrev_b32 v7, 11, v7
  v_bfe_u32 v5, v2, 3, 2
  v_lshl_add_u32 v7, v5, 1, v7
  buffer_load_ushort v248, v7, s[40:43], s14 offen
  v_lshrrev_b32 v0, 2, v3
  v_lshlrev_b32 v0, 3, v0
  v_and_b32 v7, 3, v3
  v_add_u32 v0, v0, v7
  v_lshlrev_b32 v0, 8, v0
  v_lshl_add_u32 v0, v4, 4, v0
  s_lshl_b32 s92, s76, 20
  s_lshl_b32 s7, s77, 17
  s_add_u32 s92, s92, s7
  s_lshl_b32 s7, s3, 14
  s_add_u32 s92, s92, s7
  s_add_u32 s93, s92, 8192
  v_lshlrev_b32 v249, 11, v4
  v_lshl_add_u32 v249, v3, 4, v249
  v_lshlrev_b32 v250, 14, v4
  v_lshl_add_u32 v250, v3, 4, v250
  buffer_load_dwordx4 v[64:67], v0, s[44:47], s92 offen offset:0 nt
  buffer_load_dwordx4 v[68:71], v0, s[44:47], s92 offen offset:64 nt
  buffer_load_dwordx4 v[72:75], v0, s[44:47], s92 offen offset:128 nt
  s_lshr_b32 s7, s2, 1
  s_and_b32 s8, s7, 1
  s_lshr_b32 s9, s7, 1
  s_lshl_b32 s8, s8, 3
  s_add_u32 s8, s8, s3
  s_mul_i32 s8, s8, 458752
  s_lshl_b32 s9, s9, 7
  s_add_u32 s16, s8, s9
  s_cmp_ge_u32 s2, 224
  s_cselect_b32 s16, 7340032, s16
  s_add_u32 s17, s16, 7168
  s_add_u32 s18, s16, 14336
  s_add_u32 s19, s16, 21504
  s_add_u32 s20, s16, 28672
  s_add_u32 s21, s16, 35840
  s_add_u32 s22, s16, 43008
  s_add_u32 s23, s16, 50176
  s_lshl_b32 s8, s77, 8
  s_and_b32 s9, s3, 3
  s_lshl_b32 s9, s9, 16
  s_add_u32 s8, s8, s9
  s_mul_i32 s10, s76, 229376
  s_lshl_b32 s11, s76, 18
  s_cmp_lt_u32 s3, 4
  s_cselect_b32 s10, s11, s10
  s_cselect_b32 s60, s64, s60
  s_cselect_b32 s61, s65, s61
  s_cselect_b32 s62, s66, s62
  s_add_u32 s24, s10, s8
  s_add_u32 s25, s24, 4096
  s_add_u32 s26, s24, 8192
  s_add_u32 s27, s24, 12288
  s_lshl_b32 s8, s76, 12
  s_lshl_b32 s9, s3, 9
  s_add_u32 s8, s8, s9
  s_add_u32 s28, s8, 0x100000
  s_add_u32 s29, s28, 0x40000
  s_mul_i32 s8, s76, 448
  s_mul_i32 s9, s3, 14336
  s_add_u32 s8, s8, s9
  s_add_u32 s30, s8, 0x200000
  s_add_u32 s31, s30, 229376
  s_lshr_b32 s7, s76, 3
  s_and_b32 s8, s76, 7
  s_lshl_b32 s9, s3, 2
  s_add_u32 s9, s9, s7
  s_lshl_b32 s10, s9, 15
  s_lshl_b32 s11, s8, 9
  s_add_u32 s10, s10, s11
  s_add_u32 s32, s10, 0x400000
  s_add_u32 s33, s32, 8192
  s_add_u32 s34, s32, 16384
  s_add_u32 s35, s32, 24576
  s_lshl_b32 s10, s9, 10
  s_lshl_b32 s11, s8, 7
  s_add_u32 s10, s10, s11
  s_add_u32 s36, s10, 0x600000
  s_waitcnt vmcnt(8)
  v_lshlrev_b32 v200, 16, v192
  v_and_b32 v201, 0xffff0000, v192
  v_lshlrev_b32 v202, 16, v193
  v_and_b32 v203, 0xffff0000, v193
  v_lshlrev_b32 v204, 16, v194
  v_and_b32 v205, 0xffff0000, v194
  v_lshlrev_b32 v206, 16, v195
  v_and_b32 v207, 0xffff0000, v195
  v_lshlrev_b32 v208, 16, v196
  v_and_b32 v209, 0xffff0000, v196
  v_lshlrev_b32 v210, 16, v197
  v_and_b32 v211, 0xffff0000, v197
  v_lshlrev_b32 v212, 16, v198
  v_and_b32 v213, 0xffff0000, v198
  v_lshlrev_b32 v214, 16, v199
  v_and_b32 v215, 0xffff0000, v199
  v_add_f32 v8, v200, v201
  v_add_f32 v8, v8, v202
  v_add_f32 v8, v8, v203
  v_add_f32 v8, v8, v204
  v_add_f32 v8, v8, v205
  v_add_f32 v8, v8, v206
  v_add_f32 v8, v8, v207
  v_add_f32 v8, v8, v208
  v_add_f32 v8, v8, v209
  v_add_f32 v8, v8, v210
  v_add_f32 v8, v8, v211
  v_add_f32 v8, v8, v212
  v_add_f32 v8, v8, v213
  v_add_f32 v8, v8, v214
  v_add_f32 v8, v8, v215
  s_nop 1
  v_add_f32_dpp v9, v8, v8 quad_perm:[1,0,3,2] row_mask:0xf bank_mask:0xf
  v_mov_b32 v8, v9
  s_nop 1
  v_add_f32_dpp v9, v8, v8 quad_perm:[2,3,0,1] row_mask:0xf bank_mask:0xf
  v_mov_b32 v8, v9
  s_nop 1
  v_add_f32_dpp v9, v8, v8 row_half_mirror row_mask:0xf bank_mask:0xf
  v_mov_b32 v8, v9
  s_nop 1
  v_add_f32_dpp v9, v8, v8 row_mirror row_mask:0xf bank_mask:0xf
  v_mov_b32 v8, v9
  v_mov_b32 v9, v8
  v_mov_b32 v10, v8
  s_nop 1
  v_permlane16_swap_b32 v9, v10
  s_nop 0
  v_add_f32 v8, v9, v10
  v_mov_b32 v9, v8
  v_mov_b32 v10, v8
  s_nop 1
  v_permlane32_swap_b32 v9, v10
  s_nop 0
  v_add_f32 v8, v9, v10
  v_mul_f32 v11, 0x3a800000, v8
  v_mov_b32 v8, 0
  v_sub_f32 v9, v200, v11
  v_fmac_f32 v8, v9, v9
  v_sub_f32 v9, v201, v11
  v_fmac_f32 v8, v9, v9
  v_sub_f32 v9, v202, v11
  v_fmac_f32 v8, v9, v9
  v_sub_f32 v9, v203, v11
  v_fmac_f32 v8, v9, v9
  v_sub_f32 v9, v204, v11
  v_fmac_f32 v8, v9, v9
  v_sub_f32 v9, v205, v11
  v_fmac_f32 v8, v9, v9
  v_sub_f32 v9, v206, v11
  v_fmac_f32 v8, v9, v9
  v_sub_f32 v9, v207, v11
  v_fmac_f32 v8, v9, v9
  v_sub_f32 v9, v208, v11
  v_fmac_f32 v8, v9, v9
  v_sub_f32 v9, v209, v11
  v_fmac_f32 v8, v9, v9
  v_sub_f32 v9, v210, v11
  v_fmac_f32 v8, v9, v9
  v_sub_f32 v9, v211, v11
  v_fmac_f32 v8, v9, v9
  v_sub_f32 v9, v212, v11
  v_fmac_f32 v8, v9, v9
  v_sub_f32 v9, v213, v11
  v_fmac_f32 v8, v9, v9
  v_sub_f32 v9, v214, v11
  v_fmac_f32 v8, v9, v9
  v_sub_f32 v9, v215, v11
  v_fmac_f32 v8, v9, v9
  s_nop 1
  v_add_f32_dpp v9, v8, v8 quad_perm:[1,0,3,2] row_mask:0xf bank_mask:0xf
  v_mov_b32 v8, v9
  s_nop 1
  v_add_f32_dpp v9, v8, v8 quad_perm:[2,3,0,1] row_mask:0xf bank_mask:0xf
  v_mov_b32 v8, v9
  s_nop 1
  v_add_f32_dpp v9, v8, v8 row_half_mirror row_mask:0xf bank_mask:0xf
  v_mov_b32 v8, v9
  s_nop 1
  v_add_f32_dpp v9, v8, v8 row_mirror row_mask:0xf bank_mask:0xf
  v_mov_b32 v8, v9
  v_mov_b32 v9, v8
  v_mov_b32 v10, v8
  s_nop 1
  v_permlane16_swap_b32 v9, v10
  s_nop 0
  v_add_f32 v8, v9, v10
  v_mov_b32 v9, v8
  v_mov_b32 v10, v8
  s_nop 1
  v_permlane32_swap_b32 v9, v10
  s_nop 0
  v_add_f32 v8, v9, v10
  v_mul_f32 v8, 0x3a800000, v8
  v_cvt_pk_bf16_f32 v9, v11, v11
  v_lshlrev_b32 v11, 16, v9
  v_cvt_pk_bf16_f32 v9, v8, v8
  v_lshlrev_b32 v8, 16, v9
  v_add_f32 v8, 0x3727c5ac, v8
  v_cvt_pk_bf16_f32 v9, v8, v8
  v_lshlrev_b32 v8, 16, v9
  v_sqrt_f32 v13, v8
  s_nop 0
  v_cvt_pk_bf16_f32 v9, v13, v13
  v_lshlrev_b32 v13, 16, v9
  v_rcp_f32 v12, v13
  s_nop 0
  v_sub_f32 v200, v200, v11
  v_sub_f32 v201, v201, v11
  v_sub_f32 v202, v202, v11
  v_sub_f32 v203, v203, v11
  v_sub_f32 v204, v204, v11
  v_sub_f32 v205, v205, v11
  v_sub_f32 v206, v206, v11
  v_sub_f32 v207, v207, v11
  v_sub_f32 v208, v208, v11
  v_sub_f32 v209, v209, v11
  v_sub_f32 v210, v210, v11
  v_sub_f32 v211, v211, v11
  v_sub_f32 v212, v212, v11
  v_sub_f32 v213, v213, v11
  v_sub_f32 v214, v214, v11
  v_sub_f32 v215, v215, v11
  v_cvt_pk_bf16_f32 v9, v200, v201
  v_lshlrev_b32 v200, 16, v9
  v_and_b32 v201, 0xffff0000, v9
  v_cvt_pk_bf16_f32 v9, v202, v203
  v_lshlrev_b32 v202, 16, v9
  v_and_b32 v203, 0xffff0000, v9
  v_cvt_pk_bf16_f32 v9, v204, v205
  v_lshlrev_b32 v204, 16, v9
  v_and_b32 v205, 0xffff0000, v9
  v_cvt_pk_bf16_f32 v9, v206, v207
  v_lshlrev_b32 v206, 16, v9
  v_and_b32 v207, 0xffff0000, v9
  v_cvt_pk_bf16_f32 v9, v208, v209
  v_lshlrev_b32 v208, 16, v9
  v_and_b32 v209, 0xffff0000, v9
  v_cvt_pk_bf16_f32 v9, v210, v211
  v_lshlrev_b32 v210, 16, v9
  v_and_b32 v211, 0xffff0000, v9
  v_cvt_pk_bf16_f32 v9, v212, v213
  v_lshlrev_b32 v212, 16, v9
  v_and_b32 v213, 0xffff0000, v9
  v_cvt_pk_bf16_f32 v9, v214, v215
  v_lshlrev_b32 v214, 16, v9
  v_and_b32 v215, 0xffff0000, v9
  v_mul_f32 v9, v200, v12
  v_fma_f32 v10, -v9, v13, v200
  v_fma_f32 v200, v10, v12, v9
  v_mul_f32 v9, v201, v12
  v_fma_f32 v10, -v9, v13, v201
  v_fma_f32 v201, v10, v12, v9
  v_mul_f32 v9, v202, v12
  v_fma_f32 v10, -v9, v13, v202
  v_fma_f32 v202, v10, v12, v9
  v_mul_f32 v9, v203, v12
  v_fma_f32 v10, -v9, v13, v203
  v_fma_f32 v203, v10, v12, v9
  v_mul_f32 v9, v204, v12
  v_fma_f32 v10, -v9, v13, v204
  v_fma_f32 v204, v10, v12, v9
  v_mul_f32 v9, v205, v12
  v_fma_f32 v10, -v9, v13, v205
  v_fma_f32 v205, v10, v12, v9
  v_mul_f32 v9, v206, v12
  v_fma_f32 v10, -v9, v13, v206
  v_fma_f32 v206, v10, v12, v9
  v_mul_f32 v9, v207, v12
  v_fma_f32 v10, -v9, v13, v207
  v_fma_f32 v207, v10, v12, v9
  v_mul_f32 v9, v208, v12
  v_fma_f32 v10, -v9, v13, v208
  v_fma_f32 v208, v10, v12, v9
  v_mul_f32 v9, v209, v12
  v_fma_f32 v10, -v9, v13, v209
  v_fma_f32 v209, v10, v12, v9
  v_mul_f32 v9, v210, v12
  v_fma_f32 v10, -v9, v13, v210
  v_fma_f32 v210, v10, v12, v9
  v_mul_f32 v9, v211, v12
  v_fma_f32 v10, -v9, v13, v211
  v_fma_f32 v211, v10, v12, v9
  v_mul_f32 v9, v212, v12
  v_fma_f32 v10, -v9, v13, v212
  v_fma_f32 v212, v10, v12, v9
  v_mul_f32 v9, v213, v12
  v_fma_f32 v10, -v9, v13, v213
  v_fma_f32 v213, v10, v12, v9
  v_mul_f32 v9, v214, v12
  v_fma_f32 v10, -v9, v13, v214
  v_fma_f32 v214, v10, v12, v9
  v_mul_f32 v9, v215, v12
  v_fma_f32 v10, -v9, v13, v215
  v_fma_f32 v215, v10, v12, v9
  v_cvt_pk_bf16_f32 v192, v200, v201
  v_cvt_pk_bf16_f32 v193, v202, v203
  v_cvt_pk_bf16_f32 v194, v204, v205
  v_cvt_pk_bf16_f32 v195, v206, v207
  v_cvt_pk_bf16_f32 v196, v208, v209
  v_cvt_pk_bf16_f32 v197, v210, v211
  v_cvt_pk_bf16_f32 v198, v212, v213
  v_cvt_pk_bf16_f32 v199, v214, v215
  v_add_u32 v5, s94, v251
  ds_write_b128 v5, v[192:195] offset:0
  ds_write_b128 v5, v[196:199] offset:1024
  s_lshl_b32 s7, s3, 2
  v_mov_b32 v5, s7
  v_mov_b32 v6, 0
  ds_write_b32 v5, v6 offset:23040
  s_waitcnt lgkmcnt(0)
  s_barrier
  s_add_u32 s6, s6, 0x9e3779b9
  s_and_b32 s7, s6, 0xff
  s_bfe_u32 s8, s6, 0x80008
  v_mov_b32 v246, s7
  v_mov_b32 v247, s8
  v_and_b32 v5, 7, v3
  v_lshlrev_b32 v5, 11, v5
  v_lshrrev_b32 v6, 3, v3
  v_lshlrev_b32 v6, 2, v6
  v_add_u32 v6, v6, v4
  v_lshl_add_u32 v9, v6, 3, v5
  s_lshr_b32 s7, s2, 6
  s_lshl_b32 s7, s7, 3
  s_add_u32 s7, s7, s3
  s_lshl_b32 s7, s7, 6
  v_add_u32 v9, s7, v9
  ds_read_b64 v[240:241], v9 offset:0
  v_lshrrev_b32 v5, 1, v4
  s_lshl_b32 s7, s3, 1
  v_add_u32 v5, s7, v5
  v_mul_u32_u24 v5, 2176, v5
  v_and_b32 v6, 7, v3
  v_mul_u32_u24 v6, 272, v6
  v_add_u32 v5, v5, v6
  v_and_b32 v6, 1, v4
  v_lshl_add_u32 v60, v6, 4, v5
  v_add_u32 v5, 28672, v60
  v_mul_u32_u24 v7, 272, v3
  v_lshl_add_u32 v7, v4, 4, v7
  s_mul_i32 s7, s3, 4352
  v_add_u32 v7, s7, v7
  v_and_b32 v9, 31, v2
  v_lshrrev_b32 v252, 1, v9
  v_lshlrev_b32 v252, 4, v252
  v_lshl_add_u32 v252, v9, 7, v252
  v_lshrrev_b32 v10, 5, v2
  v_lshlrev_b32 v14, 17, v10
  v_lshl_add_u32 v14, v9, 4, v14
  v_lshlrev_b32 v244, 12, v10
  v_lshl_add_u32 v244, v9, 4, v244
  v_lshlrev_b32 v245, 4, v10
  v_min_u32 v11, 27, v9
  v_mul_u32_u24 v61, 114688, v10
  v_lshl_add_u32 v61, v11, 4, v61
  v_mul_u32_u24 v10, 17408, v10
  v_add_u32 v252, v252, v10
  s_lshl_b32 s7, s3, 2
  v_add_u32 v252, s7, v252
  v_lshrrev_b32 v255, 1, v3
  v_lshlrev_b32 v255, 4, v255
  v_lshl_add_u32 v255, v3, 7, v255
  v_mul_u32_u24 v10, 8704, v4
  v_add_u32 v255, v255, v10
  v_add_u32 v255, s7, v255
  s_lshl_b32 s7, s3, 9
  v_lshlrev_b32 v253, 4, v9
  v_add_u32 v253, s7, v253
  s_lshl_b32 s7, s3, 4
  v_add_u32 v9, s7, v3
  v_and_b32 v10, 1, v4
  v_lshlrev_b32 v10, 4, v10
  v_lshl_add_u32 v243, v9, 5, v10
  v_lshrrev_b32 v9, 3, v9
  v_lshl_add_u32 v242, v9, 4, v243
  v_lshrrev_b32 v9, 1, v4
  v_mul_u32_u24 v9, 8704, v9
  v_add_u32 v242, v242, v9
  v_and_b32 v6, 7, v3
  v_lshlrev_b32 v6, 8, v6
  v_lshl_add_u32 v6, v4, 4, v6
  s_and_b32 s7, s3, 3
  s_lshl_b32 s7, s7, 6
  s_cmp_lt_u32 s3, 4
  s_mov_b32 s9, 18432
  s_cselect_b32 s8, 20480, s9
  s_add_u32 s7, s7, s8
  v_add_u32 v254, s7, v6
  buffer_load_dwordx4 v[76:79], v0, s[44:47], s92 offen offset:192 nt
  buffer_load_dwordx4 v[80:83], v0, s[44:47], s92 offen offset:1024 nt
  buffer_load_dwordx4 v[84:87], v0, s[44:47], s92 offen offset:1088 nt
  s_waitcnt vmcnt(7) lgkmcnt(0)
  v_mov_b32 v15, v14
  v_perm_b32 v8, v20, v16, s4
  v_perm_b32 v9, v28, v24, s4
  v_perm_b32 v12, v20, v16, s5
  v_perm_b32 v13, v28, v24, s5
  v_mfma_f32_16x16x16_bf16 v[192:195], v[240:241], v[8:9], 0
  v_perm_b32 v8, v21, v17, s4
  v_perm_b32 v9, v29, v25, s4
  v_mfma_f32_16x16x16_bf16 v[196:199], v[240:241], v[12:13], 0
  v_perm_b32 v12, v21, v17, s5
  v_perm_b32 v13, v29, v25, s5
  v_mfma_f32_16x16x16_bf16 v[200:203], v[240:241], v[8:9], 0
  v_perm_b32 v8, v22, v18, s4
  v_perm_b32 v9, v30, v26, s4
  v_mfma_f32_16x16x16_bf16 v[204:207], v[240:241], v[12:13], 0
  v_perm_b32 v12, v22, v18, s5
  v_perm_b32 v13, v30, v26, s5
  v_mfma_f32_16x16x16_bf16 v[208:211], v[240:241], v[8:9], 0
  v_perm_b32 v8, v23, v19, s4
  v_perm_b32 v9, v31, v27, s4
  v_mfma_f32_16x16x16_bf16 v[212:215], v[240:241], v[12:13], 0
  v_perm_b32 v12, v23, v19, s5
  v_perm_b32 v13, v31, v27, s5
  v_mfma_f32_16x16x16_bf16 v[216:219], v[240:241], v[8:9], 0
  v_mfma_f32_16x16x16_bf16 v[220:223], v[240:241], v[12:13], 0
  s_nop 7
  s_mov_b32 exec_lo, 0xff00ff
  s_mov_b32 exec_hi, 0xff00ff00
  ds_write_b128 v5, v[192:195] offset:0
  ds_write_b128 v5, v[196:199] offset:32
  ds_write_b128 v5, v[200:203] offset:64
  ds_write_b128 v5, v[204:207] offset:96
  ds_write_b128 v5, v[208:211] offset:128
  ds_write_b128 v5, v[212:215] offset:160
  ds_write_b128 v5, v[216:219] offset:192
  ds_write_b128 v5, v[220:223] offset:224
  s_mov_b64 exec, -1
  s_waitcnt lgkmcnt(0)
  s_barrier
  s_lshr_b32 s7, s2, 6
  s_lshl_b32 s7, s7, 3
  s_add_u32 s7, s7, s3
  s_lshl_b32 s7, s7, 14
  s_and_b32 s8, s2, 63
  s_lshl_b32 s8, s8, 8
  s_add_u32 s7, s7, s8
  s_add_u32 s80, s7, 0x100000
  v_add_u32 v5, 28672, v255
  ds_read_b32 v224, v5 offset:0
  ds_read_b32 v225, v5 offset:32
  ds_read_b32 v226, v5 offset:64
  ds_read_b32 v227, v5 offset:96
  ds_read_b32 v228, v5 offset:2176
  ds_read_b32 v229, v5 offset:2208
  ds_read_b32 v230, v5 offset:2240
  ds_read_b32 v231, v5 offset:2272
  ds_read_b32 v232, v5 offset:4352
  ds_read_b32 v233, v5 offset:4384
  ds_read_b32 v234, v5 offset:4416
  ds_read_b32 v235, v5 offset:4448
  ds_read_b32 v236, v5 offset:6528
  ds_read_b32 v237, v5 offset:6560
  ds_read_b32 v238, v5 offset:6592
  ds_read_b32 v239, v5 offset:6624
  s_waitcnt lgkmcnt(0)
  v_add_f32 v224, v224, v228
  v_add_f32 v232, v232, v236
  v_add_f32 v225, v225, v229
  v_add_f32 v233, v233, v237
  v_add_f32 v226, v226, v230
  v_add_f32 v234, v234, v238
  v_add_f32 v227, v227, v231
  v_add_f32 v235, v235, v239
  v_add_f32 v224, v224, v232
  v_add_f32 v225, v225, v233
  v_add_f32 v226, v226, v234
  v_add_f32 v227, v227, v235
  v_mov_b32 v228, v224
  v_mov_b32 v229, v225
  v_mov_b32 v230, v226
  v_mov_b32 v231, v227
  s_nop 1
  v_permlane16_swap_b32 v224, v228
  v_permlane16_swap_b32 v225, v229
  v_permlane16_swap_b32 v226, v230
  v_permlane16_swap_b32 v227, v231
  s_nop 0
  v_add_f32 v224, v224, v228
  v_add_f32 v225, v225, v229
  v_add_f32 v226, v226, v230
  v_add_f32 v227, v227, v231
  v_mov_b32 v228, v224
  v_mov_b32 v229, v225
  v_mov_b32 v230, v226
  v_mov_b32 v231, v227
  s_nop 1
  v_permlane32_swap_b32 v224, v228
  v_permlane32_swap_b32 v225, v229
  v_permlane32_swap_b32 v226, v230
  v_permlane32_swap_b32 v227, v231
  s_nop 0
  v_add_f32 v224, v224, v228
  v_add_f32 v225, v225, v229
  v_add_f32 v226, v226, v230
  v_add_f32 v227, v227, v231
  v_add_u32 v224, 0x80, v224
  v_add_u32 v225, 0x80, v225
  v_add_u32 v226, 0x80, v226
  v_add_u32 v227, 0x80, v227
  v_and_or_b32 v224, v224, s95, v246
  v_and_or_b32 v225, v225, s95, v247
  v_and_or_b32 v226, v226, s95, v246
  v_and_or_b32 v227, v227, s95, v247
  s_mov_b64 exec, 0xffff
  buffer_store_dwordx4 v[224:227], v251, s[68:71], s80 offen sc1
  s_mov_b64 exec, -1
  s_nop 0
  buffer_load_dwordx4 v[88:91], v0, s[44:47], s92 offen offset:1152 nt
  buffer_load_dwordx4 v[92:95], v0, s[44:47], s92 offen offset:1216 nt
  buffer_load_dwordx4 v[96:99], v0, s[44:47], s93 offen offset:0 nt
  buffer_load_dwordx4 v[100:103], v0, s[44:47], s93 offen offset:64 nt
  s_waitcnt vmcnt(3)
  buffer_load_dwordx4 v[104:107], v0, s[44:47], s93 offen offset:128 nt
  s_waitcnt vmcnt(3)
  buffer_load_dwordx4 v[108:111], v0, s[44:47], s93 offen offset:192 nt
  s_waitcnt vmcnt(3)
  buffer_load_dwordx4 v[112:115], v0, s[44:47], s93 offen offset:1024 nt
  s_waitcnt vmcnt(3)
  buffer_load_dwordx4 v[116:119], v0, s[44:47], s93 offen offset:1088 nt
  s_waitcnt vmcnt(3)
  buffer_load_dwordx4 v[120:123], v0, s[44:47], s93 offen offset:1152 nt
  s_waitcnt vmcnt(3)
  buffer_load_dwordx4 v[124:127], v0, s[44:47], s93 offen offset:1216 nt
  s_waitcnt vmcnt(3)
  buffer_load_dwordx4 v[128:131], v249, s[48:51], s92 offen offset:0 nt
  s_waitcnt vmcnt(3)
  buffer_load_dwordx4 v[132:135], v249, s[48:51], s92 offen offset:256 nt
  s_waitcnt vmcnt(3)
  buffer_load_dwordx4 v[136:139], v249, s[48:51], s92 offen offset:512 nt
  s_waitcnt vmcnt(3)
  buffer_load_dwordx4 v[140:143], v249, s[48:51], s92 offen offset:768 nt
  s_waitcnt vmcnt(3)
  buffer_load_dwordx4 v[224:227], v14, s[68:71], s28 offen
  s_waitcnt vmcnt(3)
  buffer_load_dwordx4 v[228:231], v14, s[68:71], s29 offen
  s_waitcnt vmcnt(3)
  buffer_load_dwordx4 v[144:147], v249, s[48:51], s92 offen offset:1024 nt
  s_waitcnt vmcnt(3)
  buffer_load_dwordx4 v[148:151], v249, s[48:51], s92 offen offset:1280 nt
  s_waitcnt vmcnt(3)
  buffer_load_dwordx4 v[152:155], v249, s[48:51], s92 offen offset:1536 nt
  buffer_load_dwordx4 v[156:159], v249, s[48:51], s92 offen offset:1792 nt
  buffer_load_dwordx4 v[160:163], v249, s[48:51], s93 offen offset:0 nt
  buffer_load_dwordx4 v[164:167], v249, s[48:51], s93 offen offset:256 nt
  s_waitcnt vmcnt(6)
  v_xor_b32 v9, v224, v246
  v_xor_b32 v10, v225, v247
  v_or_b32 v8, v9, v10
  v_xor_b32 v9, v226, v246
  v_xor_b32 v10, v227, v247
  v_or3_b32 v8, v8, v9, v10
  v_xor_b32 v9, v228, v246
  v_xor_b32 v10, v229, v247
  v_or3_b32 v8, v8, v9, v10
  v_xor_b32 v9, v230, v246
  v_xor_b32 v10, v231, v247
  v_or3_b32 v8, v8, v9, v10
  v_and_b32 v8, 0xff, v8
  v_cmp_ne_u32 vcc, 0, v8
  s_nop 0
  s_cmp_eq_u64 vcc, 0
  s_cbranch_scc1 L_g_ok
L_g_retry:
  buffer_load_dwordx4 v[224:227], v14, s[68:71], s28 offen sc1
  buffer_load_dwordx4 v[228:231], v14, s[68:71], s29 offen sc1
  s_waitcnt vmcnt(0)
  v_xor_b32 v9, v224, v246
  v_xor_b32 v10, v225, v247
  v_or_b32 v8, v9, v10
  v_xor_b32 v9, v226, v246
  v_xor_b32 v10, v227, v247
  v_or3_b32 v8, v8, v9, v10
  v_xor_b32 v9, v228, v246
  v_xor_b32 v10, v229, v247
  v_or3_b32 v8, v8, v9, v10
  v_xor_b32 v9, v230, v246
  v_xor_b32 v10, v231, v247
  v_or3_b32 v8, v8, v9, v10
  v_and_b32 v8, 0xff, v8
  v_cmp_ne_u32 vcc, 0, v8
  s_nop 0
  s_cmp_eq_u64 vcc, 0
  s_cbranch_scc1 L_g_ok
  s_sub_u32 s15, s15, 1
  s_cmp_lg_u32 s15, 0
  s_cbranch_scc1 L_g_retry
L_g_ok:
  v_and_b32 v224, s95, v224
  v_and_b32 v225, s95, v225
  v_and_b32 v226, s95, v226
  v_and_b32 v227, s95, v227
  v_and_b32 v228, s95, v228
  v_and_b32 v229, s95, v229
  v_and_b32 v230, s95, v230
  v_and_b32 v231, s95, v231
  v_add_f32 v224, v224, v228
  v_add_f32 v225, v225, v229
  v_add_f32 v226, v226, v230
  v_add_f32 v227, v227, v231
  v_mov_b32 v192, v224
  v_mov_b32 v193, v225
  v_mov_b32 v194, v226
  v_mov_b32 v195, v227
  s_nop 1
  v_permlane32_swap_b32 v224, v192
  v_permlane32_swap_b32 v225, v193
  v_permlane32_swap_b32 v226, v194
  v_permlane32_swap_b32 v227, v195
  s_nop 0
  v_add_f32 v224, v224, v192
  v_add_f32 v225, v225, v193
  v_add_f32 v226, v226, v194
  v_add_f32 v227, v227, v195
  v_cvt_pk_bf16_f32 v224, v224, v225
  v_cvt_pk_bf16_f32 v225, v226, v227
  v_lshlrev_b32 v5, 3, v2
  s_lshl_b32 s7, s3, 8
  v_add_u32 v5, s7, v5
  s_mov_b32 exec_hi, 0
  ds_write_b64 v5, v[224:225] offset:16384
  s_mov_b64 exec, -1
  s_lshl_b32 s7, s3, 2
  v_mov_b32 v5, s7
  v_mov_b32 v6, 1
  ds_write_b32 v5, v6 offset:23040
  buffer_load_dwordx4 v[168:171], v249, s[48:51], s93 offen offset:512 nt
  buffer_load_dwordx4 v[172:175], v249, s[48:51], s93 offen offset:768 nt
  buffer_load_dwordx4 v[176:179], v249, s[48:51], s93 offen offset:1024 nt
  buffer_load_dwordx4 v[180:183], v249, s[48:51], s93 offen offset:1280 nt
  v_mov_b32 v5, 0
L_qf:
  ds_read_b128 v[192:195], v5 offset:23040
  ds_read_b128 v[196:199], v5 offset:23056
  s_waitcnt lgkmcnt(0)
  v_and_b32 v8, v192, v193
  v_and_b32 v8, v8, v194
  v_and_b32 v8, v8, v195
  v_and_b32 v8, v8, v196
  v_and_b32 v8, v8, v197
  v_and_b32 v8, v8, v198
  v_and_b32 v8, v8, v199
  v_cmp_ne_u32 vcc, 1, v8
  s_nop 0
  s_cmp_eq_u64 vcc, 0
  s_cbranch_scc1 L_qf_ok
  s_sub_u32 s15, s15, 1
  s_cmp_lg_u32 s15, 0
  s_cbranch_scc1 L_qf
L_qf_ok:
  v_and_b32 v5, 7, v3
  v_lshlrev_b32 v5, 8, v5
  v_lshl_add_u32 v5, v4, 4, v5
  ds_read_b128 v[192:195], v5 offset:16384
  ds_read_b128 v[196:199], v5 offset:16448
  ds_read_b128 v[200:203], v5 offset:16512
  ds_read_b128 v[204:207], v5 offset:16576
  s_waitcnt lgkmcnt(3)
  v_mfma_f32_16x16x32_bf16 v[224:227], v[64:67], v[192:195], 0
  v_mfma_f32_16x16x32_bf16 v[228:231], v[80:83], v[192:195], 0
  v_mfma_f32_16x16x32_bf16 v[232:235], v[96:99], v[192:195], 0
  v_mfma_f32_16x16x32_bf16 v[236:239], v[112:115], v[192:195], 0
  s_waitcnt lgkmcnt(2)
  v_mfma_f32_16x16x32_bf16 v[224:227], v[68:71], v[196:199], v[224:227]
  v_mfma_f32_16x16x32_bf16 v[228:231], v[84:87], v[196:199], v[228:231]
  v_mfma_f32_16x16x32_bf16 v[232:235], v[100:103], v[196:199], v[232:235]
  v_mfma_f32_16x16x32_bf16 v[236:239], v[116:119], v[196:199], v[236:239]
  s_waitcnt lgkmcnt(1)
  v_mfma_f32_16x16x32_bf16 v[224:227], v[72:75], v[200:203], v[224:227]
  v_mfma_f32_16x16x32_bf16 v[228:231], v[88:91], v[200:203], v[228:231]
  v_mfma_f32_16x16x32_bf16 v[232:235], v[104:107], v[200:203], v[232:235]
  v_mfma_f32_16x16x32_bf16 v[236:239], v[120:123], v[200:203], v[236:239]
  s_waitcnt lgkmcnt(0)
  v_mfma_f32_16x16x32_bf16 v[224:227], v[76:79], v[204:207], v[224:227]
  v_mfma_f32_16x16x32_bf16 v[228:231], v[92:95], v[204:207], v[228:231]
  v_mfma_f32_16x16x32_bf16 v[232:235], v[108:111], v[204:207], v[232:235]
  v_mfma_f32_16x16x32_bf16 v[236:239], v[124:127], v[204:207], v[236:239]
  s_nop 7
  buffer_load_dwordx4 v[184:187], v249, s[48:51], s93 offen offset:1536 nt
  buffer_load_dwordx4 v[188:191], v249, s[48:51], s93 offen offset:1792 nt
  buffer_load_dwordx4 v[96:99], v1, s[56:59], s16 offen nt
  v_cvt_pk_bf16_f32 v9, v224, v225
  v_lshlrev_b32 v224, 16, v9
  v_and_b32 v225, 0xffff0000, v9
  v_cvt_pk_bf16_f32 v9, v226, v227
  v_lshlrev_b32 v226, 16, v9
  v_and_b32 v227, 0xffff0000, v9
  v_cvt_pk_bf16_f32 v9, v228, v229
  v_lshlrev_b32 v228, 16, v9
  v_and_b32 v229, 0xffff0000, v9
  v_cvt_pk_bf16_f32 v9, v230, v231
  v_lshlrev_b32 v230, 16, v9
  v_and_b32 v231, 0xffff0000, v9
  v_cvt_pk_bf16_f32 v9, v232, v233
  v_lshlrev_b32 v232, 16, v9
  v_and_b32 v233, 0xffff0000, v9
  v_cvt_pk_bf16_f32 v9, v234, v235
  v_lshlrev_b32 v234, 16, v9
  v_and_b32 v235, 0xffff0000, v9
  v_cvt_pk_bf16_f32 v9, v236, v237
  v_lshlrev_b32 v236, 16, v9
  v_and_b32 v237, 0xffff0000, v9
  v_cvt_pk_bf16_f32 v9, v238, v239
  v_lshlrev_b32 v238, 16, v9
  v_and_b32 v239, 0xffff0000, v9
  v_mul_f32 v224, s97, v224
  v_mul_f32 v225, s97, v225
  v_mul_f32 v226, s97, v226
  v_mul_f32 v227, s97, v227
  v_mul_f32 v228, s97, v228
  v_mul_f32 v229, s97, v229
  v_mul_f32 v230, s97, v230
  v_mul_f32 v231, s97, v231
  v_mul_f32 v232, s97, v232
  v_mul_f32 v233, s97, v233
  v_mul_f32 v234, s97, v234
  v_mul_f32 v235, s97, v235
  v_mul_f32 v236, s97, v236
  v_mul_f32 v237, s97, v237
  v_mul_f32 v238, s97, v238
  v_mul_f32 v239, s97, v239
  v_cvt_pk_bf16_f32 v9, v224, v225
  v_lshlrev_b32 v224, 16, v9
  v_and_b32 v225, 0xffff0000, v9
  v_cvt_pk_bf16_f32 v9, v226, v227
  v_lshlrev_b32 v226, 16, v9
  v_and_b32 v227, 0xffff0000, v9
  v_cvt_pk_bf16_f32 v9, v228, v229
  v_lshlrev_b32 v228, 16, v9
  v_and_b32 v229, 0xffff0000, v9
  v_cvt_pk_bf16_f32 v9, v230, v231
  v_lshlrev_b32 v230, 16, v9
  v_and_b32 v231, 0xffff0000, v9
  v_cvt_pk_bf16_f32 v9, v232, v233
  v_lshlrev_b32 v232, 16, v9
  v_and_b32 v233, 0xffff0000, v9
  v_cvt_pk_bf16_f32 v9, v234, v235
  v_lshlrev_b32 v234, 16, v9
  v_and_b32 v235, 0xffff0000, v9
  v_cvt_pk_bf16_f32 v9, v236, v237
  v_lshlrev_b32 v236, 16, v9
  v_and_b32 v237, 0xffff0000, v9
  v_cvt_pk_bf16_f32 v9, v238, v239
  v_lshlrev_b32 v238, 16, v9
  v_and_b32 v239, 0xffff0000, v9
  v_max3_f32 v11, v224, v225, v226
  v_max3_f32 v11, v11, v227, v228
  v_max3_f32 v11, v11, v229, v230
  v_max3_f32 v11, v11, v231, v232
  v_max3_f32 v11, v11, v233, v234
  v_max3_f32 v11, v11, v235, v236
  v_max3_f32 v11, v11, v237, v238
  v_max_f32 v11, v11, v239
  v_mov_b32 v9, v11
  v_mov_b32 v10, v11
  s_nop 1
  v_permlane16_swap_b32 v9, v10
  s_nop 0
  v_max_f32 v11, v9, v10
  v_mov_b32 v9, v11
  v_mov_b32 v10, v11
  s_nop 1
  v_permlane32_swap_b32 v9, v10
  s_nop 0
  v_max_f32 v11, v9, v10
  v_lshlrev_b32 v5, 5, v3
  s_lshl_b32 s7, s3, 2
  v_add_u32 v5, s7, v5
  s_mov_b64 exec, 0xff
  ds_write_b32 v5, v11 offset:22528
  s_mov_b64 exec, -1
  v_mul_f32 v11, s96, v11
  v_fma_f32 v224, v224, s96, -v11
  v_fma_f32 v225, v225, s96, -v11
  v_fma_f32 v226, v226, s96, -v11
  v_fma_f32 v227, v227, s96, -v11
  v_fma_f32 v228, v228, s96, -v11
  v_fma_f32 v229, v229, s96, -v11
  v_fma_f32 v230, v230, s96, -v11
  v_fma_f32 v231, v231, s96, -v11
  v_fma_f32 v232, v232, s96, -v11
  v_fma_f32 v233, v233, s96, -v11
  v_fma_f32 v234, v234, s96, -v11
  v_fma_f32 v235, v235, s96, -v11
  v_fma_f32 v236, v236, s96, -v11
  v_fma_f32 v237, v237, s96, -v11
  v_fma_f32 v238, v238, s96, -v11
  v_fma_f32 v239, v239, s96, -v11
  v_exp_f32 v224, v224
  v_exp_f32 v225, v225
  v_exp_f32 v226, v226
  v_exp_f32 v227, v227
  v_exp_f32 v228, v228
  v_exp_f32 v229, v229
  v_exp_f32 v230, v230
  v_exp_f32 v231, v231
  v_exp_f32 v232, v232
  v_exp_f32 v233, v233
  v_exp_f32 v234, v234
  v_exp_f32 v235, v235
  v_exp_f32 v236, v236
  v_exp_f32 v237, v237
  v_exp_f32 v238, v238
  v_exp_f32 v239, v239
  s_nop 0
  v_add_f32 v8, v224, v225
  v_add_f32 v8, v8, v226
  v_add_f32 v8, v8, v227
  v_add_f32 v8, v8, v228
  v_add_f32 v8, v8, v229
  v_add_f32 v8, v8, v230
  v_add_f32 v8, v8, v231
  v_add_f32 v8, v8, v232
  v_add_f32 v8, v8, v233
  v_add_f32 v8, v8, v234
  v_add_f32 v8, v8, v235
  v_add_f32 v8, v8, v236
  v_add_f32 v8, v8, v237
  v_add_f32 v8, v8, v238
  v_add_f32 v8, v8, v239
  v_cvt_pk_bf16_f32 v64, v224, v225
  v_cvt_pk_bf16_f32 v65, v226, v227
  v_cvt_pk_bf16_f32 v66, v228, v229
  v_cvt_pk_bf16_f32 v67, v230, v231
  v_cvt_pk_bf16_f32 v68, v232, v233
  v_cvt_pk_bf16_f32 v69, v234, v235
  v_cvt_pk_bf16_f32 v70, v236, v237
  v_cvt_pk_bf16_f32 v71, v238, v239
  v_mov_b32 v9, v8
  v_mov_b32 v10, v8
  s_nop 1
  v_permlane16_swap_b32 v9, v10
  s_nop 0
  v_add_f32 v8, v9, v10
  v_mov_b32 v9, v8
  v_mov_b32 v10, v8
  s_nop 1
  v_permlane32_swap_b32 v9, v10
  s_nop 0
  v_add_f32 v8, v9, v10
  s_mov_b64 exec, 0xff
  ds_write_b32 v5, v8 offset:22784
  s_mov_b64 exec, -1
  buffer_load_dwordx4 v[100:103], v1, s[56:59], s17 offen nt
  buffer_load_dwordx4 v[104:107], v1, s[56:59], s18 offen nt
  buffer_load_dwordx4 v[108:111], v1, s[56:59], s19 offen nt
  s_waitcnt vmcnt(12)
  v_perm_b32 v8, v132, v128, s4
  v_perm_b32 v9, v140, v136, s4
  v_perm_b32 v10, v148, v144, s4
  v_perm_b32 v11, v156, v152, s4
  v_perm_b32 v12, v132, v128, s5
  v_perm_b32 v13, v140, v136, s5
  v_perm_b32 v14, v148, v144, s5
  v_perm_b32 v15, v156, v152, s5
  v_mfma_f32_16x16x32_bf16 v[192:195], v[64:67], v[8:11], 0
  v_perm_b32 v8, v133, v129, s4
  v_perm_b32 v9, v141, v137, s4
  v_perm_b32 v10, v149, v145, s4
  v_perm_b32 v11, v157, v153, s4
  v_mfma_f32_16x16x32_bf16 v[196:199], v[64:67], v[12:15], 0
  v_perm_b32 v12, v133, v129, s5
  v_perm_b32 v13, v141, v137, s5
  v_perm_b32 v14, v149, v145, s5
  v_perm_b32 v15, v157, v153, s5
  v_mfma_f32_16x16x32_bf16 v[200:203], v[64:67], v[8:11], 0
  v_perm_b32 v8, v134, v130, s4
  v_perm_b32 v9, v142, v138, s4
  v_perm_b32 v10, v150, v146, s4
  v_perm_b32 v11, v158, v154, s4
  v_mfma_f32_16x16x32_bf16 v[204:207], v[64:67], v[12:15], 0
  v_perm_b32 v12, v134, v130, s5
  v_perm_b32 v13, v142, v138, s5
  v_perm_b32 v14, v150, v146, s5
  v_perm_b32 v15, v158, v154, s5
  v_mfma_f32_16x16x32_bf16 v[208:211], v[64:67], v[8:11], 0
  v_perm_b32 v8, v135, v131, s4
  v_perm_b32 v9, v143, v139, s4
  v_perm_b32 v10, v151, v147, s4
  v_perm_b32 v11, v159, v155, s4
  v_mfma_f32_16x16x32_bf16 v[212:215], v[64:67], v[12:15], 0
  v_perm_b32 v12, v135, v131, s5
  v_perm_b32 v13, v143, v139, s5
  v_perm_b32 v14, v151, v147, s5
  v_perm_b32 v15, v159, v155, s5
  v_mfma_f32_16x16x32_bf16 v[216:219], v[64:67], v[8:11], 0
  v_mfma_f32_16x16x32_bf16 v[220:223], v[64:67], v[12:15], 0
  buffer_load_dwordx4 v[112:115], v1, s[56:59], s20 offen nt
  buffer_load_dwordx4 v[116:119], v1, s[56:59], s21 offen nt
  buffer_load_dwordx4 v[120:123], v1, s[56:59], s22 offen nt
  buffer_load_dwordx4 v[124:127], v1, s[56:59], s23 offen nt
  buffer_load_dwordx4 v[16:19], v250, s[60:63], s24 offen offset:0 nt
  s_waitcnt vmcnt(9)
  v_perm_b32 v8, v164, v160, s4
  v_perm_b32 v9, v172, v168, s4
  v_perm_b32 v10, v180, v176, s4
  v_perm_b32 v11, v188, v184, s4
  v_perm_b32 v12, v164, v160, s5
  v_perm_b32 v13, v172, v168, s5
  v_perm_b32 v14, v180, v176, s5
  v_perm_b32 v15, v188, v184, s5
  v_mfma_f32_16x16x32_bf16 v[192:195], v[68:71], v[8:11], v[192:195]
  v_perm_b32 v8, v165, v161, s4
  v_perm_b32 v9, v173, v169, s4
  v_perm_b32 v10, v181, v177, s4
  v_perm_b32 v11, v189, v185, s4
  v_mfma_f32_16x16x32_bf16 v[196:199], v[68:71], v[12:15], v[196:199]
  v_perm_b32 v12, v165, v161, s5
  v_perm_b32 v13, v173, v169, s5
  v_perm_b32 v14, v181, v177, s5
  v_perm_b32 v15, v189, v185, s5
  v_mfma_f32_16x16x32_bf16 v[200:203], v[68:71], v[8:11], v[200:203]
  v_perm_b32 v8, v166, v162, s4
  v_perm_b32 v9, v174, v170, s4
  v_perm_b32 v10, v182, v178, s4
  v_perm_b32 v11, v190, v186, s4
  v_mfma_f32_16x16x32_bf16 v[204:207], v[68:71], v[12:15], v[204:207]
  v_perm_b32 v12, v166, v162, s5
  v_perm_b32 v13, v174, v170, s5
  v_perm_b32 v14, v182, v178, s5
  v_perm_b32 v15, v190, v186, s5
  v_mfma_f32_16x16x32_bf16 v[208:211], v[68:71], v[8:11], v[208:211]
  v_perm_b32 v8, v167, v163, s4
  v_perm_b32 v9, v175, v171, s4
  v_perm_b32 v10, v183, v179, s4
  v_perm_b32 v11, v191, v187, s4
  v_mfma_f32_16x16x32_bf16 v[212:215], v[68:71], v[12:15], v[212:215]
  v_perm_b32 v12, v167, v163, s5
  v_perm_b32 v13, v175, v171, s5
  v_perm_b32 v14, v183, v179, s5
  v_perm_b32 v15, v191, v187, s5
  v_mfma_f32_16x16x32_bf16 v[216:219], v[68:71], v[8:11], v[216:219]
  v_mfma_f32_16x16x32_bf16 v[220:223], v[68:71], v[12:15], v[220:223]
  v_add_u32 v5, 102400, v7
  s_nop 7
  s_mov_b32 exec_lo, 0xffffffff
  s_mov_b32 exec_hi, 0x0
  ds_write_b128 v5, v[192:195] offset:0
  ds_write_b128 v5, v[196:199] offset:32
  ds_write_b128 v5, v[200:203] offset:64
  ds_write_b128 v5, v[204:207] offset:96
  ds_write_b128 v5, v[208:211] offset:128
  ds_write_b128 v5, v[212:215] offset:160
  ds_write_b128 v5, v[216:219] offset:192
  ds_write_b128 v5, v[220:223] offset:224
  s_mov_b64 exec, -1
  s_waitcnt lgkmcnt(0)
  s_barrier
  s_lshl_b32 s7, s76, 15
  s_lshl_b32 s8, s77, 12
  s_add_u32 s7, s7, s8
  s_add_u32 s84, s7, 0x400000
  s_lshl_b32 s7, s3, 5
  v_mov_b32 v6, s7
  ds_read_b128 v[72:75], v6 offset:22784
  ds_read_b128 v[76:79], v6 offset:22800
  ds_read_b128 v[80:83], v6 offset:22528
  ds_read_b128 v[84:87], v6 offset:22544
  v_add_u32 v5, 102400, v252
  ds_read_b32 v224, v5 offset:0
  ds_read_b32 v225, v5 offset:32
  ds_read_b32 v226, v5 offset:64
  ds_read_b32 v227, v5 offset:96
  ds_read_b32 v228, v5 offset:4352
  ds_read_b32 v229, v5 offset:4384
  ds_read_b32 v230, v5 offset:4416
  ds_read_b32 v231, v5 offset:4448
  ds_read_b32 v232, v5 offset:8704
  ds_read_b32 v233, v5 offset:8736
  ds_read_b32 v234, v5 offset:8768
  ds_read_b32 v235, v5 offset:8800
  ds_read_b32 v236, v5 offset:13056
  ds_read_b32 v237, v5 offset:13088
  ds_read_b32 v238, v5 offset:13120
  ds_read_b32 v239, v5 offset:13152
  s_waitcnt lgkmcnt(15)
  v_max3_f32 v88, v80, v81, v82
  v_max3_f32 v88, v88, v83, v84
  v_max3_f32 v88, v88, v85, v86
  v_max_f32 v88, v88, v87
  v_sub_f32 v80, v80, v88
  v_mul_f32 v80, s96, v80
  v_sub_f32 v81, v81, v88
  v_mul_f32 v81, s96, v81
  v_sub_f32 v82, v82, v88
  v_mul_f32 v82, s96, v82
  v_sub_f32 v83, v83, v88
  v_mul_f32 v83, s96, v83
  v_sub_f32 v84, v84, v88
  v_mul_f32 v84, s96, v84
  v_sub_f32 v85, v85, v88
  v_mul_f32 v85, s96, v85
  v_sub_f32 v86, v86, v88
  v_mul_f32 v86, s96, v86
  v_sub_f32 v87, v87, v88
  v_mul_f32 v87, s96, v87
  v_exp_f32 v80, v80
  v_exp_f32 v81, v81
  v_exp_f32 v82, v82
  v_exp_f32 v83, v83
  v_exp_f32 v84, v84
  v_exp_f32 v85, v85
  v_exp_f32 v86, v86
  v_exp_f32 v87, v87
  s_mov_b32 s12, 0
  s_mov_b32 s13, -1
  v_mul_f32 v90, v72, v80
  v_fmac_f32 v90, v73, v81
  v_fmac_f32 v90, v74, v82
  v_fmac_f32 v90, v75, v83
  v_fmac_f32 v90, v76, v84
  v_fmac_f32 v90, v77, v85
  v_fmac_f32 v90, v78, v86
  v_fmac_f32 v90, v79, v87
  v_cndmask_b32 v72, v80, v84, s[12:13]
  v_cndmask_b32 v73, v81, v85, s[12:13]
  v_cndmask_b32 v74, v82, v86, s[12:13]
  v_cndmask_b32 v75, v83, v87, s[12:13]
  s_waitcnt lgkmcnt(0)
  v_mul_f32 v224, v224, v72
  v_mul_f32 v225, v225, v72
  v_mul_f32 v226, v226, v72
  v_mul_f32 v227, v227, v72
  v_fmac_f32 v224, v228, v73
  v_fmac_f32 v225, v229, v73
  v_fmac_f32 v226, v230, v73
  v_fmac_f32 v227, v231, v73
  v_fmac_f32 v224, v232, v74
  v_fmac_f32 v225, v233, v74
  v_fmac_f32 v226, v234, v74
  v_fmac_f32 v227, v235, v74
  v_fmac_f32 v224, v236, v75
  v_fmac_f32 v225, v237, v75
  v_fmac_f32 v226, v238, v75
  v_fmac_f32 v227, v239, v75
  v_mov_b32 v228, v224
  v_mov_b32 v229, v225
  v_mov_b32 v230, v226
  v_mov_b32 v231, v227
  s_nop 1
  v_permlane32_swap_b32 v224, v228
  v_permlane32_swap_b32 v225, v229
  v_permlane32_swap_b32 v226, v230
  v_permlane32_swap_b32 v227, v231
  s_nop 0
  v_add_f32 v224, v224, v228
  v_add_f32 v225, v225, v229
  v_add_f32 v226, v226, v230
  v_add_f32 v227, v227, v231
  v_add_u32 v224, 0x80, v224
  v_add_u32 v225, 0x80, v225
  v_add_u32 v226, 0x80, v226
  v_add_u32 v227, 0x80, v227
  v_and_or_b32 v224, v224, s95, v246
  v_and_or_b32 v225, v225, s95, v247
  v_and_or_b32 v226, v226, s95, v246
  v_and_or_b32 v227, v227, s95, v247
  s_mov_b32 exec_hi, 0
  buffer_store_dwordx4 v[224:227], v253, s[68:71], s84 offen sc1
  s_mov_b64 exec, -1
  v_mov_b32 v89, s6
  v_mov_b32 v91, s6
  s_lshl_b32 s7, s76, 10
  s_lshl_b32 s8, s77, 4
  s_add_u32 s7, s7, s8
  s_lshl_b32 s8, s3, 7
  s_add_u32 s7, s7, s8
  s_add_u32 s85, s7, 0x600000
  v_mov_b32 v6, 0
  s_mov_b64 exec, 1
  buffer_store_dwordx4 v[88:91], v6, s[68:71], s85 offen sc1
  s_mov_b64 exec, -1
  v_and_b32 v5, 7, v3
  v_lshlrev_b32 v5, 11, v5
  v_lshrrev_b32 v6, 3, v3
  v_lshlrev_b32 v6, 2, v6
  v_add_u32 v6, v6, v4
  v_lshl_add_u32 v10, v6, 4, v5
  s_lshr_b32 s7, s2, 1
  s_and_b32 s7, s7, 1
  s_lshl_b32 s7, s7, 3
  s_add_u32 s7, s7, s3
  s_lshl_b32 s7, s7, 7
  v_add_u32 v10, s7, v10
  ds_read_b128 v[172:175], v10 offset:0
  v_add_u32 v5, 65536, v60
  buffer_load_dwordx4 v[20:23], v250, s[60:63], s24 offen offset:2048 nt
  buffer_load_dwordx4 v[24:27], v250, s[60:63], s25 offen offset:0 nt
  buffer_load_dwordx4 v[28:31], v250, s[60:63], s25 offen offset:2048 nt
  buffer_load_dwordx4 v[32:35], v250, s[60:63], s26 offen offset:0 nt
  buffer_load_dwordx4 v[36:39], v250, s[60:63], s26 offen offset:2048 nt
  buffer_load_dwordx4 v[40:43], v250, s[60:63], s27 offen offset:0 nt
  buffer_load_dwordx4 v[44:47], v250, s[60:63], s27 offen offset:2048 nt
  s_waitcnt vmcnt(10) lgkmcnt(0)
  v_perm_b32 v8, v100, v96, s4
  v_perm_b32 v9, v108, v104, s4
  v_perm_b32 v10, v116, v112, s4
  v_perm_b32 v11, v124, v120, s4
  v_perm_b32 v12, v100, v96, s5
  v_perm_b32 v13, v108, v104, s5
  v_perm_b32 v14, v116, v112, s5
  v_perm_b32 v15, v124, v120, s5
  v_mfma_f32_16x16x32_bf16 v[192:195], v[172:175], v[8:11], 0
  v_perm_b32 v8, v101, v97, s4
  v_perm_b32 v9, v109, v105, s4
  v_perm_b32 v10, v117, v113, s4
  v_perm_b32 v11, v125, v121, s4
  v_mfma_f32_16x16x32_bf16 v[196:199], v[172:175], v[12:15], 0
  v_perm_b32 v12, v101, v97, s5
  v_perm_b32 v13, v109, v105, s5
  v_perm_b32 v14, v117, v113, s5
  v_perm_b32 v15, v125, v121, s5
  v_mfma_f32_16x16x32_bf16 v[200:203], v[172:175], v[8:11], 0
  v_perm_b32 v8, v102, v98, s4
  v_perm_b32 v9, v110, v106, s4
  v_perm_b32 v10, v118, v114, s4
  v_perm_b32 v11, v126, v122, s4
  v_mfma_f32_16x16x32_bf16 v[204:207], v[172:175], v[12:15], 0
  v_perm_b32 v12, v102, v98, s5
  v_perm_b32 v13, v110, v106, s5
  v_perm_b32 v14, v118, v114, s5
  v_perm_b32 v15, v126, v122, s5
  v_mfma_f32_16x16x32_bf16 v[208:211], v[172:175], v[8:11], 0
  v_perm_b32 v8, v103, v99, s4
  v_perm_b32 v9, v111, v107, s4
  v_perm_b32 v10, v119, v115, s4
  v_perm_b32 v11, v127, v123, s4
  v_mfma_f32_16x16x32_bf16 v[212:215], v[172:175], v[12:15], 0
  v_perm_b32 v12, v103, v99, s5
  v_perm_b32 v13, v111, v107, s5
  v_perm_b32 v14, v119, v115, s5
  v_perm_b32 v15, v127, v123, s5
  v_mfma_f32_16x16x32_bf16 v[216:219], v[172:175], v[8:11], 0
  v_mfma_f32_16x16x32_bf16 v[220:223], v[172:175], v[12:15], 0
  s_nop 7
  s_mov_b32 exec_lo, 0xff00ff
  s_mov_b32 exec_hi, 0xff00ff00
  ds_write_b128 v5, v[192:195] offset:0
  ds_write_b128 v5, v[196:199] offset:32
  ds_write_b128 v5, v[200:203] offset:64
  ds_write_b128 v5, v[204:207] offset:96
  ds_write_b128 v5, v[208:211] offset:128
  ds_write_b128 v5, v[212:215] offset:160
  ds_write_b128 v5, v[216:219] offset:192
  ds_write_b128 v5, v[220:223] offset:224
  s_mov_b64 exec, -1
  s_waitcnt lgkmcnt(0)
  s_barrier
  s_and_b32 s7, s2, 3
  s_and_b32 s8, s7, 1
  s_lshr_b32 s9, s7, 1
  s_lshl_b32 s8, s8, 1
  s_add_u32 s8, s8, s9
  s_lshl_b32 s8, s8, 3
  s_add_u32 s8, s8, s3
  s_mul_i32 s8, s8, 14336
  s_lshr_b32 s10, s2, 2
  s_lshl_b32 s10, s10, 8
  s_add_u32 s8, s8, s10
  s_add_u32 s80, s8, 0x200000
  s_cmp_ge_u32 s2, 224
  s_cselect_b32 s80, 0x1000000, s80
  v_add_u32 v5, 65536, v255
  ds_read_b32 v224, v5 offset:0
  ds_read_b32 v225, v5 offset:32
  ds_read_b32 v226, v5 offset:64
  ds_read_b32 v227, v5 offset:96
  ds_read_b32 v228, v5 offset:2176
  ds_read_b32 v229, v5 offset:2208
  ds_read_b32 v230, v5 offset:2240
  ds_read_b32 v231, v5 offset:2272
  ds_read_b32 v232, v5 offset:4352
  ds_read_b32 v233, v5 offset:4384
  ds_read_b32 v234, v5 offset:4416
  ds_read_b32 v235, v5 offset:4448
  ds_read_b32 v236, v5 offset:6528
  ds_read_b32 v237, v5 offset:6560
  ds_read_b32 v238, v5 offset:6592
  ds_read_b32 v239, v5 offset:6624
  s_waitcnt lgkmcnt(0)
  v_add_f32 v224, v224, v228
  v_add_f32 v232, v232, v236
  v_add_f32 v225, v225, v229
  v_add_f32 v233, v233, v237
  v_add_f32 v226, v226, v230
  v_add_f32 v234, v234, v238
  v_add_f32 v227, v227, v231
  v_add_f32 v235, v235, v239
  v_add_f32 v224, v224, v232
  v_add_f32 v225, v225, v233
  v_add_f32 v226, v226, v234
  v_add_f32 v227, v227, v235
  v_mov_b32 v228, v224
  v_mov_b32 v229, v225
  v_mov_b32 v230, v226
  v_mov_b32 v231, v227
  s_nop 1
  v_permlane16_swap_b32 v224, v228
  v_permlane16_swap_b32 v225, v229
  v_permlane16_swap_b32 v226, v230
  v_permlane16_swap_b32 v227, v231
  s_nop 0
  v_add_f32 v224, v224, v228
  v_add_f32 v225, v225, v229
  v_add_f32 v226, v226, v230
  v_add_f32 v227, v227, v231
  v_mov_b32 v228, v224
  v_mov_b32 v229, v225
  v_mov_b32 v230, v226
  v_mov_b32 v231, v227
  s_nop 1
  v_permlane32_swap_b32 v224, v228
  v_permlane32_swap_b32 v225, v229
  v_permlane32_swap_b32 v226, v230
  v_permlane32_swap_b32 v227, v231
  s_nop 0
  v_add_f32 v224, v224, v228
  v_add_f32 v225, v225, v229
  v_add_f32 v226, v226, v230
  v_add_f32 v227, v227, v231
  v_add_u32 v224, 0x80, v224
  v_add_u32 v225, 0x80, v225
  v_add_u32 v226, 0x80, v226
  v_add_u32 v227, 0x80, v227
  v_and_or_b32 v224, v224, s95, v246
  v_and_or_b32 v225, v225, s95, v247
  v_and_or_b32 v226, v226, s95, v246
  v_and_or_b32 v227, v227, s95, v247
  s_mov_b64 exec, 0xffff
  buffer_store_dwordx4 v[224:227], v251, s[68:71], s80 offen sc1
  s_mov_b64 exec, -1
  s_nop 0
  buffer_load_dwordx4 v[144:147], v245, s[68:71], s36 offen offset:0 sc1
  buffer_load_dwordx4 v[148:151], v245, s[68:71], s36 offen offset:32 sc1
  buffer_load_dwordx4 v[152:155], v245, s[68:71], s36 offen offset:64 sc1
  buffer_load_dwordx4 v[156:159], v245, s[68:71], s36 offen offset:96 sc1
  buffer_load_dwordx4 v[64:67], v244, s[68:71], s32 offen
  buffer_load_dwordx4 v[68:71], v244, s[68:71], s33 offen
  buffer_load_dwordx4 v[72:75], v244, s[68:71], s34 offen
  buffer_load_dwordx4 v[76:79], v244, s[68:71], s35 offen
  s_waitcnt vmcnt(9)
  v_perm_b32 v128, v20, v16, s4
  v_perm_b32 v129, v28, v24, s4
  v_perm_b32 v130, v36, v32, s4
  v_perm_b32 v131, v44, v40, s4
  v_perm_b32 v132, v20, v16, s5
  v_perm_b32 v133, v28, v24, s5
  v_perm_b32 v134, v36, v32, s5
  v_perm_b32 v135, v44, v40, s5
  v_perm_b32 v136, v21, v17, s4
  v_perm_b32 v137, v29, v25, s4
  v_perm_b32 v138, v37, v33, s4
  v_perm_b32 v139, v45, v41, s4
  v_perm_b32 v140, v21, v17, s5
  v_perm_b32 v141, v29, v25, s5
  v_perm_b32 v142, v37, v33, s5
  v_perm_b32 v143, v45, v41, s5
  v_perm_b32 v176, v22, v18, s4
  v_perm_b32 v177, v30, v26, s4
  v_perm_b32 v178, v38, v34, s4
  v_perm_b32 v179, v46, v42, s4
  v_perm_b32 v180, v22, v18, s5
  v_perm_b32 v181, v30, v26, s5
  v_perm_b32 v182, v38, v34, s5
  v_perm_b32 v183, v46, v42, s5
  v_perm_b32 v184, v23, v19, s4
  v_perm_b32 v185, v31, v27, s4
  v_perm_b32 v186, v39, v35, s4
  v_perm_b32 v187, v47, v43, s4
  v_perm_b32 v188, v23, v19, s5
  v_perm_b32 v189, v31, v27, s5
  v_perm_b32 v190, v39, v35, s5
  v_perm_b32 v191, v47, v43, s5
  s_waitcnt vmcnt(0)
  v_min3_u32 v8, v145, v147, v147
  v_max3_u32 v9, v145, v147, v147
  v_min3_u32 v8, v8, v149, v151
  v_max3_u32 v9, v9, v149, v151
  v_min3_u32 v8, v8, v153, v155
  v_max3_u32 v9, v9, v153, v155
  v_min3_u32 v8, v8, v157, v159
  v_max3_u32 v9, v9, v157, v159
  v_cmp_ne_u32 vcc, s6, v8
  v_cmp_ne_u32 s[12:13], s6, v9
  s_nop 0
  s_or_b64 vcc, vcc, s[12:13]
  s_cmp_eq_u64 vcc, 0
  s_cbranch_scc1 L_pc1
  s_branch L_pollc
L_pc1:
  v_xor_b32 v9, v64, v246
  v_xor_b32 v10, v65, v247
  v_or_b32 v8, v9, v10
  v_xor_b32 v9, v66, v246
  v_xor_b32 v10, v67, v247
  v_or3_b32 v8, v8, v9, v10
  v_xor_b32 v9, v68, v246
  v_xor_b32 v10, v69, v247
  v_or3_b32 v8, v8, v9, v10
  v_xor_b32 v9, v70, v246
  v_xor_b32 v10, v71, v247
  v_or3_b32 v8, v8, v9, v10
  v_xor_b32 v9, v72, v246
  v_xor_b32 v10, v73, v247
  v_or3_b32 v8, v8, v9, v10
  v_xor_b32 v9, v74, v246
  v_xor_b32 v10, v75, v247
  v_or3_b32 v8, v8, v9, v10
  v_xor_b32 v9, v76, v246
  v_xor_b32 v10, v77, v247
  v_or3_b32 v8, v8, v9, v10
  v_xor_b32 v9, v78, v246
  v_xor_b32 v10, v79, v247
  v_or3_b32 v8, v8, v9, v10
  v_and_b32 v8, 0xff, v8
  v_cmp_ne_u32 vcc, 0, v8
  s_nop 0
  s_cmp_eq_u64 vcc, 0
  s_cbranch_scc1 L_gc_ok
L_pollc:
  s_sleep 3
  buffer_load_dwordx4 v[144:147], v245, s[68:71], s36 offen offset:0 sc1
  buffer_load_dwordx4 v[148:151], v245, s[68:71], s36 offen offset:32 sc1
  buffer_load_dwordx4 v[152:155], v245, s[68:71], s36 offen offset:64 sc1
  buffer_load_dwordx4 v[156:159], v245, s[68:71], s36 offen offset:96 sc1
  s_waitcnt vmcnt(0)
  v_min3_u32 v8, v145, v147, v147
  v_max3_u32 v9, v145, v147, v147
  v_min3_u32 v8, v8, v149, v151
  v_max3_u32 v9, v9, v149, v151
  v_min3_u32 v8, v8, v153, v155
  v_max3_u32 v9, v9, v153, v155
  v_min3_u32 v8, v8, v157, v159
  v_max3_u32 v9, v9, v157, v159
  v_cmp_ne_u32 vcc, s6, v8
  v_cmp_ne_u32 s[12:13], s6, v9
  s_nop 0
  s_or_b64 vcc, vcc, s[12:13]
  s_cmp_eq_u64 vcc, 0
  s_cbranch_scc1 L_pc2
  s_sub_u32 s15, s15, 1
  s_cmp_lg_u32 s15, 0
  s_cbranch_scc1 L_pollc
  s_branch L_gc_ok
L_pc2:
  buffer_load_dwordx4 v[64:67], v244, s[68:71], s32 offen sc1
  buffer_load_dwordx4 v[68:71], v244, s[68:71], s33 offen sc1
  buffer_load_dwordx4 v[72:75], v244, s[68:71], s34 offen sc1
  buffer_load_dwordx4 v[76:79], v244, s[68:71], s35 offen sc1
  s_waitcnt vmcnt(0)
  v_xor_b32 v9, v64, v246
  v_xor_b32 v10, v65, v247
  v_or_b32 v8, v9, v10
  v_xor_b32 v9, v66, v246
  v_xor_b32 v10, v67, v247
  v_or3_b32 v8, v8, v9, v10
  v_xor_b32 v9, v68, v246
  v_xor_b32 v10, v69, v247
  v_or3_b32 v8, v8, v9, v10
  v_xor_b32 v9, v70, v246
  v_xor_b32 v10, v71, v247
  v_or3_b32 v8, v8, v9, v10
  v_xor_b32 v9, v72, v246
  v_xor_b32 v10, v73, v247
  v_or3_b32 v8, v8, v9, v10
  v_xor_b32 v9, v74, v246
  v_xor_b32 v10, v75, v247
  v_or3_b32 v8, v8, v9, v10
  v_xor_b32 v9, v76, v246
  v_xor_b32 v10, v77, v247
  v_or3_b32 v8, v8, v9, v10
  v_xor_b32 v9, v78, v246
  v_xor_b32 v10, v79, v247
  v_or3_b32 v8, v8, v9, v10
  v_and_b32 v8, 0xff, v8
  v_cmp_ne_u32 vcc, 0, v8
  s_nop 0
  s_cmp_eq_u64 vcc, 0
  s_cbranch_scc1 L_gc_ok
  s_sub_u32 s15, s15, 1
  s_cmp_lg_u32 s15, 0
  s_cbranch_scc1 L_pc2
L_gc_ok:
  buffer_load_dwordx4 v[48:51], v61, s[68:71], s30 offen
  buffer_load_dwordx4 v[52:55], v61, s[68:71], s31 offen
  v_and_b32 v64, s95, v64
  v_and_b32 v65, s95, v65
  v_and_b32 v66, s95, v66
  v_and_b32 v67, s95, v67
  v_and_b32 v68, s95, v68
  v_and_b32 v69, s95, v69
  v_and_b32 v70, s95, v70
  v_and_b32 v71, s95, v71
  v_and_b32 v72, s95, v72
  v_and_b32 v73, s95, v73
  v_and_b32 v74, s95, v74
  v_and_b32 v75, s95, v75
  v_and_b32 v76, s95, v76
  v_and_b32 v77, s95, v77
  v_and_b32 v78, s95, v78
  v_and_b32 v79, s95, v79
  v_max3_f32 v11, v144, v148, v152
  v_max_f32 v11, v11, v156
  v_mov_b32 v9, v11
  v_mov_b32 v10, v11
  s_nop 1
  v_permlane32_swap_b32 v9, v10
  s_nop 0
  v_max_f32 v11, v9, v10
  v_sub_f32 v160, v144, v11
  v_mul_f32 v160, s96, v160
  v_sub_f32 v161, v148, v11
  v_mul_f32 v161, s96, v161
  v_sub_f32 v162, v152, v11
  v_mul_f32 v162, s96, v162
  v_sub_f32 v163, v156, v11
  v_mul_f32 v163, s96, v163
  v_exp_f32 v160, v160
  v_exp_f32 v161, v161
  v_exp_f32 v162, v162
  v_exp_f32 v163, v163
  s_nop 0
  v_mul_f32 v12, v160, v146
  v_fmac_f32 v12, v161, v150
  v_fmac_f32 v12, v162, v154
  v_fmac_f32 v12, v163, v158
  v_mov_b32 v9, v12
  v_mov_b32 v10, v12
  s_nop 1
  v_permlane32_swap_b32 v9, v10
  s_nop 0
  v_add_f32 v12, v9, v10
  v_rcp_f32 v12, v12
  v_mul_f32 v164, v160, v64
  v_mul_f32 v165, v160, v65
  v_mul_f32 v166, v160, v66
  v_mul_f32 v167, v160, v67
  v_fmac_f32 v164, v161, v68
  v_fmac_f32 v165, v161, v69
  v_fmac_f32 v166, v161, v70
  v_fmac_f32 v167, v161, v71
  v_fmac_f32 v164, v162, v72
  v_fmac_f32 v165, v162, v73
  v_fmac_f32 v166, v162, v74
  v_fmac_f32 v167, v162, v75
  v_fmac_f32 v164, v163, v76
  v_fmac_f32 v165, v163, v77
  v_fmac_f32 v166, v163, v78
  v_fmac_f32 v167, v163, v79
  v_mov_b32 v168, v164
  v_mov_b32 v169, v165
  v_mov_b32 v170, v166
  v_mov_b32 v171, v167
  s_nop 1
  v_permlane32_swap_b32 v164, v168
  v_permlane32_swap_b32 v165, v169
  v_permlane32_swap_b32 v166, v170
  v_permlane32_swap_b32 v167, v171
  s_nop 0
  v_add_f32 v164, v164, v168
  v_add_f32 v165, v165, v169
  v_add_f32 v166, v166, v170
  v_add_f32 v167, v167, v171
  v_mul_f32 v164, v164, v12
  v_mul_f32 v165, v165, v12
  v_mul_f32 v166, v166, v12
  v_mul_f32 v167, v167, v12
  v_cvt_pk_bf16_f32 v164, v164, v165
  v_cvt_pk_bf16_f32 v165, v166, v167
  v_lshlrev_b32 v6, 3, v2
  s_lshl_b32 s7, s3, 8
  v_add_u32 v6, s7, v6
  s_mov_b32 exec_hi, 0
  ds_write_b64 v6, v[164:165] offset:20480
  s_mov_b64 exec, -1
  s_waitcnt vmcnt(0)
  v_xor_b32 v9, v48, v246
  v_xor_b32 v10, v49, v247
  v_or_b32 v8, v9, v10
  v_xor_b32 v9, v50, v246
  v_xor_b32 v10, v51, v247
  v_or3_b32 v8, v8, v9, v10
  v_xor_b32 v9, v52, v246
  v_xor_b32 v10, v53, v247
  v_or3_b32 v8, v8, v9, v10
  v_xor_b32 v9, v54, v246
  v_xor_b32 v10, v55, v247
  v_or3_b32 v8, v8, v9, v10
  v_and_b32 v8, 0xff, v8
  v_cmp_ne_u32 vcc, 0, v8
  s_nop 0
  s_cmp_eq_u64 vcc, 0
  s_cbranch_scc1 L_h_ok
L_h_retry:
  s_sleep 1
  buffer_load_dwordx4 v[48:51], v61, s[68:71], s30 offen sc1
  buffer_load_dwordx4 v[52:55], v61, s[68:71], s31 offen sc1
  s_waitcnt vmcnt(0)
  v_xor_b32 v9, v48, v246
  v_xor_b32 v10, v49, v247
  v_or_b32 v8, v9, v10
  v_xor_b32 v9, v50, v246
  v_xor_b32 v10, v51, v247
  v_or3_b32 v8, v8, v9, v10
  v_xor_b32 v9, v52, v246
  v_xor_b32 v10, v53, v247
  v_or3_b32 v8, v8, v9, v10
  v_xor_b32 v9, v54, v246
  v_xor_b32 v10, v55, v247
  v_or3_b32 v8, v8, v9, v10
  v_and_b32 v8, 0xff, v8
  v_cmp_ne_u32 vcc, 0, v8
  s_nop 0
  s_cmp_eq_u64 vcc, 0
  s_cbranch_scc1 L_h_ok
  s_sub_u32 s15, s15, 1
  s_cmp_lg_u32 s15, 0
  s_cbranch_scc1 L_h_retry
L_h_ok:
  v_and_b32 v48, s95, v48
  v_and_b32 v49, s95, v49
  v_and_b32 v50, s95, v50
  v_and_b32 v51, s95, v51
  v_and_b32 v52, s95, v52
  v_and_b32 v53, s95, v53
  v_and_b32 v54, s95, v54
  v_and_b32 v55, s95, v55
  v_mov_b32 v56, v48
  v_mov_b32 v57, v49
  v_mov_b32 v58, v50
  v_mov_b32 v59, v51
  s_nop 1
  v_permlane32_swap_b32 v48, v56
  v_permlane32_swap_b32 v49, v57
  v_permlane32_swap_b32 v50, v58
  v_permlane32_swap_b32 v51, v59
  s_nop 0
  v_add_f32 v48, v48, v56
  v_add_f32 v49, v49, v57
  v_add_f32 v50, v50, v58
  v_add_f32 v51, v51, v59
  v_mov_b32 v56, v52
  v_mov_b32 v57, v53
  v_mov_b32 v58, v54
  v_mov_b32 v59, v55
  s_nop 1
  v_permlane32_swap_b32 v52, v56
  v_permlane32_swap_b32 v53, v57
  v_permlane32_swap_b32 v54, v58
  v_permlane32_swap_b32 v55, v59
  s_nop 0
  v_add_f32 v52, v52, v56
  v_add_f32 v53, v53, v57
  v_add_f32 v54, v54, v58
  v_add_f32 v55, v55, v59
  v_cvt_pk_bf16_f32 v9, v48, v49
  v_lshlrev_b32 v48, 16, v9
  v_and_b32 v49, 0xffff0000, v9
  v_cvt_pk_bf16_f32 v9, v50, v51
  v_lshlrev_b32 v50, 16, v9
  v_and_b32 v51, 0xffff0000, v9
  v_cvt_pk_bf16_f32 v9, v52, v53
  v_lshlrev_b32 v52, 16, v9
  v_and_b32 v53, 0xffff0000, v9
  v_cvt_pk_bf16_f32 v9, v54, v55
  v_lshlrev_b32 v54, 16, v9
  v_and_b32 v55, 0xffff0000, v9
  v_mul_f32 v48, s96, v48
  v_mul_f32 v49, s96, v49
  v_mul_f32 v50, s96, v50
  v_mul_f32 v51, s96, v51
  v_exp_f32 v48, -v48
  v_exp_f32 v49, -v49
  v_exp_f32 v50, -v50
  v_exp_f32 v51, -v51
  s_nop 0
  v_add_f32 v48, 1.0, v48
  v_add_f32 v49, 1.0, v49
  v_add_f32 v50, 1.0, v50
  v_add_f32 v51, 1.0, v51
  v_rcp_f32 v48, v48
  v_rcp_f32 v49, v49
  v_rcp_f32 v50, v50
  v_rcp_f32 v51, v51
  s_nop 0
  v_cvt_pk_bf16_f32 v9, v48, v49
  v_lshlrev_b32 v48, 16, v9
  v_and_b32 v49, 0xffff0000, v9
  v_cvt_pk_bf16_f32 v9, v50, v51
  v_lshlrev_b32 v50, 16, v9
  v_and_b32 v51, 0xffff0000, v9
  v_mul_f32 v48, v48, v52
  v_mul_f32 v49, v49, v53
  v_mul_f32 v50, v50, v54
  v_mul_f32 v51, v51, v55
  v_cmp_gt_u32 vcc, 28, v2
  v_cvt_pk_bf16_f32 v48, v48, v49
  v_cvt_pk_bf16_f32 v49, v50, v51
  s_cmp_lt_u32 s3, 4
  s_mov_b32 s9, 11264
  s_cselect_b32 s8, 102400, s9
  v_add_u32 v5, s8, v7
  v_cndmask_b32 v48, 0, v48, vcc
  v_cndmask_b32 v49, 0, v49, vcc
  s_mov_b32 exec_hi, 0
  ds_write_b64 v6, v[48:49] offset:18432
  s_mov_b64 exec, -1
  s_lshl_b32 s7, s2, 12
  s_add_u32 s90, s7, 0x800000
  s_add_u32 s91, s7, 0xa00000
  s_waitcnt lgkmcnt(0)
  s_barrier
  ds_read_b128 v[172:175], v254
  s_waitcnt lgkmcnt(0)
  v_mfma_f32_16x16x32_bf16 v[192:195], v[172:175], v[128:131], 0
  v_mfma_f32_16x16x32_bf16 v[196:199], v[172:175], v[132:135], 0
  v_mfma_f32_16x16x32_bf16 v[200:203], v[172:175], v[136:139], 0
  v_mfma_f32_16x16x32_bf16 v[204:207], v[172:175], v[140:143], 0
  v_mfma_f32_16x16x32_bf16 v[208:211], v[172:175], v[176:179], 0
  v_mfma_f32_16x16x32_bf16 v[212:215], v[172:175], v[180:183], 0
  v_mfma_f32_16x16x32_bf16 v[216:219], v[172:175], v[184:187], 0
  v_mfma_f32_16x16x32_bf16 v[220:223], v[172:175], v[188:191], 0
  s_nop 7
  s_mov_b32 exec_lo, 0xffffffff
  s_mov_b32 exec_hi, 0x0
  ds_write_b128 v5, v[192:195] offset:0
  ds_write_b128 v5, v[196:199] offset:32
  ds_write_b128 v5, v[200:203] offset:64
  ds_write_b128 v5, v[204:207] offset:96
  ds_write_b128 v5, v[208:211] offset:128
  ds_write_b128 v5, v[212:215] offset:160
  ds_write_b128 v5, v[216:219] offset:192
  ds_write_b128 v5, v[220:223] offset:224
  s_mov_b64 exec, -1
  s_waitcnt lgkmcnt(0)
  s_barrier
  v_add_u32 v5, 102400, v242
  ds_read_b128 v[224:227], v5 offset:0
  ds_read_b128 v[228:231], v5 offset:4352
  v_add_u32 v5, 28672, v242
  ds_read_b128 v[128:131], v5 offset:0
  ds_read_b128 v[132:135], v5 offset:4352
  s_waitcnt lgkmcnt(2)
  v_add_f32 v224, v224, v228
  v_add_f32 v225, v225, v229
  v_add_f32 v226, v226, v230
  v_add_f32 v227, v227, v231
  v_mov_b32 v228, v224
  v_mov_b32 v229, v225
  v_mov_b32 v230, v226
  v_mov_b32 v231, v227
  s_nop 1
  v_permlane32_swap_b32 v224, v228
  v_permlane32_swap_b32 v225, v229
  v_permlane32_swap_b32 v226, v230
  v_permlane32_swap_b32 v227, v231
  s_nop 0
  v_add_f32 v224, v224, v228
  v_add_f32 v225, v225, v229
  v_add_f32 v226, v226, v230
  v_add_f32 v227, v227, v231
  v_add_u32 v224, 0x80, v224
  v_add_u32 v225, 0x80, v225
  v_add_u32 v226, 0x80, v226
  v_add_u32 v227, 0x80, v227
  v_and_or_b32 v224, v224, s95, v246
  v_and_or_b32 v225, v225, s95, v247
  v_and_or_b32 v226, v226, s95, v246
  v_and_or_b32 v227, v227, s95, v247
  s_mov_b32 exec_hi, 0
  buffer_store_dwordx4 v[224:227], v243, s[68:71], s90 offen sc1
  s_mov_b64 exec, -1
  s_nop 0
  s_waitcnt lgkmcnt(0)
  v_add_f32 v128, v128, v132
  v_add_f32 v129, v129, v133
  v_add_f32 v130, v130, v134
  v_add_f32 v131, v131, v135
  v_mov_b32 v132, v128
  v_mov_b32 v133, v129
  v_mov_b32 v134, v130
  v_mov_b32 v135, v131
  s_nop 1
  v_permlane32_swap_b32 v128, v132
  v_permlane32_swap_b32 v129, v133
  v_permlane32_swap_b32 v130, v134
  v_permlane32_swap_b32 v131, v135
  s_nop 0
  v_add_f32 v128, v128, v132
  v_add_f32 v129, v129, v133
  v_add_f32 v130, v130, v134
  v_add_f32 v131, v131, v135
  v_add_u32 v128, 0x80, v128
  v_add_u32 v129, 0x80, v129
  v_add_u32 v130, 0x80, v130
  v_add_u32 v131, 0x80, v131
  v_and_or_b32 v128, v128, s95, v246
  v_and_or_b32 v129, v129, s95, v247
  v_and_or_b32 v130, v130, s95, v246
  v_and_or_b32 v131, v131, s95, v247
  s_mov_b32 exec_hi, 0
  buffer_store_dwordx4 v[128:131], v243, s[68:71], s91 offen sc1
  s_mov_b64 exec, -1
  s_nop 0
  v_lshlrev_b32 v5, 12, v4
  v_lshrrev_b32 v6, 3, v3
  v_lshl_add_u32 v5, v6, 21, v5
  v_and_b32 v6, 7, v3
  v_lshl_add_u32 v5, v6, 4, v5
  s_lshl_b32 s8, s77, 17
  s_lshl_b32 s9, s76, 7
  s_add_u32 s8, s8, s9
  s_lshl_b32 s9, s3, 14
  s_add_u32 s8, s8, s9
  s_add_u32 s80, s8, 0x800000
L_polld:
  buffer_load_dwordx4 v[64:67], v5, s[68:71], s80 offen sc1
  s_waitcnt vmcnt(0)
  v_xor_b32 v9, v64, v246
  v_xor_b32 v10, v65, v247
  v_or_b32 v8, v9, v10
  v_xor_b32 v9, v66, v246
  v_xor_b32 v10, v67, v247
  v_or3_b32 v8, v8, v9, v10
  v_and_b32 v8, 0xff, v8
  v_cmp_ne_u32 vcc, 0, v8
  s_nop 0
  s_cmp_eq_u64 vcc, 0
  s_cbranch_scc1 L_polld_ok
  s_sleep 1
  s_sub_u32 s15, s15, 1
  s_cmp_lg_u32 s15, 0
  s_cbranch_scc1 L_polld
L_polld_ok:
  v_and_b32 v64, s95, v64
  v_and_b32 v65, s95, v65
  v_and_b32 v66, s95, v66
  v_and_b32 v67, s95, v67
  v_mov_b32 v68, v64
  v_mov_b32 v69, v65
  v_mov_b32 v70, v66
  v_mov_b32 v71, v67
  s_nop 1
  v_permlane16_swap_b32 v64, v68
  v_permlane16_swap_b32 v65, v69
  v_permlane16_swap_b32 v66, v70
  v_permlane16_swap_b32 v67, v71
  s_nop 0
  v_add_f32 v64, v64, v68
  v_add_f32 v65, v65, v69
  v_add_f32 v66, v66, v70
  v_add_f32 v67, v67, v71
  v_mov_b32 v68, v64
  v_mov_b32 v69, v65
  v_mov_b32 v70, v66
  v_mov_b32 v71, v67
  s_nop 1
  v_permlane32_swap_b32 v64, v68
  v_permlane32_swap_b32 v65, v69
  v_permlane32_swap_b32 v66, v70
  v_permlane32_swap_b32 v67, v71
  s_nop 0
  v_add_f32 v64, v64, v68
  v_add_f32 v65, v65, v69
  v_add_f32 v66, v66, v70
  v_add_f32 v67, v67, v71
  s_lshl_b32 s7, s3, 8
  v_add_u32 v5, s7, v251
  s_mov_b64 exec, 0xffff
  ds_write_b128 v5, v[64:67] offset:24576
  s_mov_b64 exec, -1
  s_waitcnt lgkmcnt(0)
  s_barrier
  s_cmp_lg_u32 s3, 0
  s_cbranch_scc1 L_done
  v_lshlrev_b32 v6, 2, v2
  ds_read_b32 v64, v6 offset:24576
  ds_read_b32 v65, v6 offset:24832
  ds_read_b32 v66, v6 offset:25088
  ds_read_b32 v67, v6 offset:25344
  ds_read_b32 v68, v6 offset:25600
  ds_read_b32 v69, v6 offset:25856
  ds_read_b32 v70, v6 offset:26112
  ds_read_b32 v71, v6 offset:26368
  s_waitcnt lgkmcnt(0)
  v_add_f32 v64, v64, v68
  v_add_f32 v65, v65, v69
  v_add_f32 v66, v66, v70
  v_add_f32 v67, v67, v71
  v_add_f32 v64, v64, v66
  v_add_f32 v65, v65, v67
  v_add_f32 v64, v64, v65
  v_cvt_pk_bf16_f32 v9, v64, v64
  v_lshlrev_b32 v64, 16, v9
  v_mul_f32 v65, s96, v64
  v_exp_f32 v65, -v65
  s_nop 0
  v_add_f32 v65, 1.0, v65
  v_rcp_f32 v65, v65
  s_nop 0
  v_mul_f32 v65, v65, v64
  v_cvt_pk_bf16_f32 v9, v65, v65
  v_lshlrev_b32 v65, 16, v9
  v_mov_b32 v66, v65
  s_nop 1
  v_permlane32_swap_b32 v65, v66
  s_nop 0
  v_mul_f32 v64, v64, v66
  v_cvt_pk_bf16_f32 v9, v64, v64
  v_lshlrev_b32 v64, 16, v9
  v_lshlrev_b32 v248, 16, v248
  v_add_f32 v64, v64, v248
  v_cvt_pk_bf16_f32 v64, v64, v64
  v_and_b32 v5, 7, v2
  v_lshlrev_b32 v5, 11, v5
  v_bfe_u32 v6, v2, 3, 2
  v_lshl_add_u32 v5, v6, 1, v5
  s_mov_b32 exec_hi, 0
  buffer_store_short v64, v5, s[72:75], s14 offen
  s_mov_b64 exec, -1
  s_cmp_lg_u32 s2, 0
  s_cbranch_scc1 L_done
  v_mov_b32 v5, s6
  v_mov_b32 v6, 0
  s_mov_b64 exec, 1
  buffer_store_dword v5, v6, s[68:71], 0 offen sc1
L_done:
  s_endpgm
.section .rodata,"a"
.p2align 6
.amdhsa_kernel recurrent_scan__gqa_block_cached__glu_gated_glu__decode_kernel
  .amdhsa_next_free_vgpr 256
  .amdhsa_next_free_sgpr 102
  .amdhsa_accum_offset 256
  .amdhsa_group_segment_fixed_size 0
  .amdhsa_kernarg_size 96
  .amdhsa_user_sgpr_count 2
  .amdhsa_user_sgpr_kernarg_segment_ptr 1
  .amdhsa_system_sgpr_workgroup_id_x 1
.end_amdhsa_kernel
```
